```python
import torch

def _softmax(x, axis=-1):
    return torch.softmax(x, dim=axis)
def _gelu(x):
    return torch.nn.functional.gelu(x, approximate="tanh")
def _silu(x):
    return torch.nn.functional.silu(x)
def _sigmoid(x):
    return torch.sigmoid(x)
def _layernorm(x, axis=-1, eps=1e-5):
    m = x.mean(dim=axis, keepdim=True)
    v = x.var(dim=axis, keepdim=True, unbiased=False)
    return (x - m) / torch.sqrt(v + eps)
def _scatter_add(tgt, idx, src, axis=0):
    return tgt.clone().index_add_(axis, idx, src)
def _segment_sum(src, seg, n):
    out = torch.zeros((n,) + src.shape[1:], dtype=src.dtype)
    return out.index_add_(0, seg, src)
def _pad(x, pw):
    flat = tuple(v for pair in reversed(pw) for v in pair)
    return torch.nn.functional.pad(x, flat)

kernel_name = 'gated_mix__sliding_block_cached__glu_gated_glu__decode'

def setup_inputs():

    _w = (lambda a: (lambda t: t.to(torch.bfloat16) if t.is_floating_point() else t)(torch.as_tensor(a)))
    def _A_setup():
        B, Sq, D = 2, 1, 1024
        Hq, Hkv, Sk, Dh = 32, 4, 32768, 128
        assert Hq % Hkv == 0, (Hq, Hkv)
        return {
            "x": _w((lambda *s: torch.randn(*s, dtype=torch.bfloat16) * 0.05)(B, Sq, D)),
            "k_cache": _w((lambda *s: torch.randn(*s, dtype=torch.bfloat16) * 6.4)(B, Hkv, Sk, Dh)),
            "v_cache": _w((lambda *s: torch.randn(*s, dtype=torch.bfloat16) * 1.6)(B, Hkv, Sk, Dh)),
            "wq": _w((lambda *s: torch.randn(*s, dtype=torch.bfloat16) * 6.4)(D, Hq * Dh) * (D ** -0.5)),
            "wo": _w((lambda *s: torch.randn(*s, dtype=torch.bfloat16) * 1.6)(Hq * Dh, D) * ((Hq * Dh) ** -0.5)),
        }
    _A_in = _A_setup()

    def _B_setup():
        B, S, D, F = 2, 1, 1024, 3584
        return {
            "x": _w((lambda *s: torch.randn(*s, dtype=torch.bfloat16) * 0.05)(B, S, D)),
            "w_gate": _w((lambda *s: torch.randn(*s, dtype=torch.bfloat16) * 0.8)(D, F)),
            "w_up": _w((lambda *s: torch.randn(*s, dtype=torch.bfloat16) * 0.05)(D, F)),
            "w_down": _w((lambda *s: torch.randn(*s, dtype=torch.bfloat16) * 0.05)(F, D)),
        }
    _B_in = _B_setup()

    return {
        "A_x": _A_in["x"],
        "A_k_cache": _A_in["k_cache"],
        "A_v_cache": _A_in["v_cache"],
        "A_wq": _A_in["wq"],
        "A_wo": _A_in["wo"],
        "B_x": _B_in["x"],
        "B_w_gate": _B_in["w_gate"],
        "B_w_up": _B_in["w_up"],
        "B_w_down": _B_in["w_down"],
        "gate_w": _w((lambda *s: torch.randn(*s, dtype=torch.bfloat16) * 0.05)(1024) * 16.0),
    }

def reference(A_x, A_k_cache, A_v_cache, A_wq, A_wo, B_x, B_w_gate, B_w_up, B_w_down, gate_w):
    def _A_ref(x, k_cache, v_cache, wq, wo):
        B, Sq, D = x.shape
        Hq, Dh = 32, 128
        Hkv, Sk = k_cache.shape[1], k_cache.shape[2]
        W = min(4096, max(256, Sk // 4))
        rep = Hq // Hkv
        q = (lambda x, *d: x.permute(*d))((x @ wq).reshape(B, Sq, Hq, Dh), 0, 2, 1, 3)
        k = (lambda x, n, axis: torch.repeat_interleave(x, n, dim=axis))(k_cache[:, :, Sk - W:, :], rep, axis=1)
        v = (lambda x, n, axis: torch.repeat_interleave(x, n, dim=axis))(v_cache[:, :, Sk - W:, :], rep, axis=1)
        scores = torch.einsum("bhqd,bhkd->bhqk", q, k) * (Dh ** -0.5)
        p = _softmax(scores, axis=-1)
        o = torch.einsum("bhqk,bhkd->bhqd", p, v)
        return (lambda x, *d: x.permute(*d))(o, 0, 2, 1, 3).reshape(B, Sq, Hq * Dh) @ wo

    def _B_ref(x, w_gate, w_up, w_down):
        g = torch.einsum("bsd,df->bsf", x, w_gate)
        u = torch.einsum("bsd,df->bsf", x, w_up)
        h = _sigmoid(g) * u
        return torch.einsum("bsf,fd->bsd", h, w_down)

    x = A_x
    g = _sigmoid((x * gate_w).sum(-1, keepdims=True))
    a = _A_ref(x, A_k_cache, A_v_cache, A_wq, A_wo)
    b = _B_ref(x, B_w_gate, B_w_up, B_w_down)
    return g * a + (1 - g) * b
```

```asm
; @launch grid=(256,1,1) block=(512,1,1) lds=41728
.amdgcn_target "amdgcn-amd-amdhsa--gfx950"
.text
.globl gated_mix__sliding_block_cached__glu_gated_glu__decode_kernel
.p2align 8
.type gated_mix__sliding_block_cached__glu_gated_glu__decode_kernel,@function
gated_mix__sliding_block_cached__glu_gated_glu__decode_kernel:
    s_cmp_ge_u32 s2, 256
    s_cbranch_scc1 L_exit
    s_load_dwordx2 s[4:5], s[0:1], 0
    s_load_dwordx2 s[8:9], s[0:1], 24
    s_load_dwordx2 s[40:41], s[0:1], 96
    s_lshr_b32 s49, s2, 3
    s_getpc_b64 s[68:69]
L_pc:
    s_lshl_b32 s57, s49, 9
    s_min_u32 s57, s57, L_exit-L_pc-512
    s_add_u32 s68, s68, s57
    s_addc_u32 s69, s69, 0
    v_add_co_u32 v250, vcc, s68, v0
    v_mov_b32 v251, s69
    v_lshrrev_b32 v3, 6, v0
    v_addc_co_u32 v251, vcc, 0, v251, vcc
    global_load_ubyte v252, v[250:251], off
    v_and_b32 v1, 63, v0
    s_and_b32 s48, s2, 7
    v_readfirstlane_b32 s3, v3
    s_lshr_b32 s66, s49, 3
    s_mov_b32 s6, 0x1000
    s_mov_b32 s7, 0x20000
    v_bfe_u32 v5, v1, 3, 1
    v_and_b32 v6, 0x30, v1
    v_and_b32 v7, 7, v1
    s_and_b32 s50, s3, 3
    v_lshlrev_b32 v10, 11, v5
    v_lshl_add_u32 v10, v6, 1, v10
    v_or_b32 v6, v6, v5
    v_lshlrev_b32 v7, 4, v7
    s_lshl_b32 s58, s66, 2
    s_add_u32 s58, s58, s50
    s_lshl_b32 s57, s58, 7
    s_getreg_b32 s95, hwreg(HW_REG_XCC_ID, 0, 4)
    s_cmp_ge_u32 s3, 4
    s_cbranch_scc1 L_F
    s_load_dwordx2 s[12:13], s[0:1], 8
    s_load_dwordx2 s[16:17], s[0:1], 16
    s_mov_b32 s10, 0x800000
    s_mov_b32 s11, 0x20000
    v_lshl_add_u32 v11, v6, 13, v7
    s_and_b32 s60, s49, 7
    s_lshl3_add_u32 s59, s48, s60
    s_xor_b32 s59, s59, 2
    s_lshl_b32 s59, s59, 7
    s_lshl_b32 s58, s58, 19
    s_add_u32 s58, s58, s59
    s_waitcnt lgkmcnt(0)
    s_load_dword s51, s[40:41], 0
    buffer_load_dwordx4 v[16:19], v10, s[4:7], s57 offen
    buffer_load_dwordx4 v[20:23], v10, s[4:7], s57 offen offset:16
    buffer_load_dwordx4 v[48:51], v11, s[8:11], s58 offen nt
    s_add_u32 s58, s58, 0x4000
    buffer_load_dwordx4 v[52:55], v11, s[8:11], s58 offen nt
    s_add_u32 s58, s58, 0x4000
    buffer_load_dwordx4 v[56:59], v11, s[8:11], s58 offen nt
    s_add_u32 s58, s58, 0x4000
    buffer_load_dwordx4 v[60:63], v11, s[8:11], s58 offen nt
    s_add_u32 s58, s58, 0x4000
    buffer_load_dwordx4 v[64:67], v11, s[8:11], s58 offen nt
    s_add_u32 s58, s58, 0x4000
    buffer_load_dwordx4 v[68:71], v11, s[8:11], s58 offen nt
    s_add_u32 s58, s58, 0x4000
    buffer_load_dwordx4 v[72:75], v11, s[8:11], s58 offen nt
    s_add_u32 s58, s58, 0x4000
    buffer_load_dwordx4 v[76:79], v11, s[8:11], s58 offen nt
    s_mov_b32 s14, 0x4000000
    s_mov_b32 s15, 0x20000
    s_mov_b32 s18, 0x4000000
    s_mov_b32 s19, 0x20000
    s_mov_b32 s42, 0x10000000
    s_mov_b32 s43, 0x20000
    s_and_b32 s96, s48, 1
    s_lshr_b32 s60, s48, 1
    s_lshl2_add_u32 s96, s96, s60
    s_lshl_b32 s60, s96, 23
    s_lshl_b32 s61, s49, 15
    s_add_u32 s60, s60, s61
    s_lshl_b32 s61, s50, 13
    s_add_u32 s60, s60, s61
    s_add_u32 s60, s60, 0x700000
    s_lshl2_add_u32 s57, s49, s50
    s_mov_b32 s94, 0
    s_bitcmp1_b32 s57, 1
    s_cselect_b32 s61, 0x1000, 0
    s_or_b32 s94, s94, s61
    s_bitcmp1_b32 s57, 0
    s_cselect_b32 s61, 0x880, 0
    s_or_b32 s94, s94, s61
    s_bitcmp1_b32 s57, 2
    s_cselect_b32 s61, 0x600, 0
    s_or_b32 s94, s94, s61
    s_and_b32 s61, s94, 0x1c00
    s_or_b32 s61, s61, s60
    s_and_b32 s57, s94, 0x1280
    s_or_b32 s60, s60, s57
    v_and_b32 v3, 3, v1
    v_bfe_u32 v4, v1, 2, 1
    v_lshl_add_u32 v3, v3, 2, v4
    v_lshrrev_b32 v4, 3, v1
    v_lshlrev_b32 v4, 4, v4
    v_lshl_add_u32 v12, v3, 8, v4
    s_and_b32 s57, s94, 0xc00
    v_xor_b32 v12, s57, v12
    v_lshlrev_b32 v13, 4, v1
    s_and_b32 s57, s94, 0x200
    v_xor_b32 v10, s57, v13
    v_mov_b32 v2, 0xff
    v_mov_b32 v8, 1
    v_mov_b32 v9, 0
    s_mov_b32 s56, 100000
    v_bfe_u32 v3, v1, 2, 1
    v_mul_u32_u24 v3, 0x202, v3
    v_add_u32 v3, 0x0c0c0100, v3
    v_lshlrev_b32 v4, 4, v1
    v_alignbit_b32 v3, v3, v3, v4
    v_and_b32 v4, 2, v1
    v_cmp_eq_u32 vcc, 0, v4
    v_mov_b32 v4, 0x0c0c0c0c
    s_nop 0
    v_cndmask_b32 v14, v4, v3, vcc
    v_cndmask_b32 v15, v3, v4, vcc
    s_lshl_b32 s65, s48, 3
    s_lshr_b32 s57, s49, 2
    s_add_u32 s65, s65, s57
    s_lshl_b32 s57, s50, 10
    v_add_u32 v5, s57, v13
    s_lshl_b32 s62, s96, 15
    s_lshl_b32 s57, s50, 13
    s_add_u32 s62, s62, s57
    s_add_u32 s62, s62, 0x500000
    s_add_u32 s97, s62, 4096
    s_lshl2_add_u32 s57, s96, s50
    s_mov_b32 s63, 0x05040100
    s_mov_b32 s64, 0x07060302
    s_waitcnt vmcnt(8)
    ds_write_b128 v5, v[16:19] offset:33536
    ds_write_b128 v5, v[20:23] offset:37632
    v_perm_b32 v24, v16, v16, v14
    v_perm_b32 v25, v16, v16, v15
    v_perm_b32 v26, v17, v17, v14
    v_perm_b32 v27, v17, v17, v15
    v_perm_b32 v28, v18, v18, v14
    v_perm_b32 v29, v18, v18, v15
    v_perm_b32 v30, v19, v19, v14
    v_perm_b32 v31, v19, v19, v15
    v_perm_b32 v32, v20, v20, v14
    v_perm_b32 v33, v20, v20, v15
    v_perm_b32 v34, v21, v21, v14
    v_perm_b32 v35, v21, v21, v15
    v_perm_b32 v36, v22, v22, v14
    v_perm_b32 v37, v22, v22, v15
    v_perm_b32 v38, v23, v23, v14
    v_perm_b32 v39, v23, v23, v15
    v_lshrrev_b32 v14, 3, v1
    v_lshl_add_u32 v14, v14, 8, v7
    s_and_b32 s57, s49, 7
    s_cmp_eq_u32 s57, 1
    s_cselect_b64 vcc, -1, 0
    s_waitcnt vmcnt(7)
    v_mfma_f32_16x16x16_bf16 v[40:43], v[24:25], v[48:49], 0
    v_mfma_f32_16x16x16_bf16 v[44:47], v[24:25], v[50:51], 0
    s_waitcnt vmcnt(6)
    v_mfma_f32_16x16x16_bf16 v[40:43], v[26:27], v[52:53], v[40:43]
    v_mfma_f32_16x16x16_bf16 v[44:47], v[26:27], v[54:55], v[44:47]
    s_waitcnt vmcnt(5)
    v_mfma_f32_16x16x16_bf16 v[40:43], v[28:29], v[56:57], v[40:43]
    v_mfma_f32_16x16x16_bf16 v[44:47], v[28:29], v[58:59], v[44:47]
    s_waitcnt vmcnt(4)
    s_xor_b32 s59, s60, 0x0
    buffer_load_dwordx4 v[80:83], v12, s[12:15], s59 offen nt
    v_mfma_f32_16x16x16_bf16 v[40:43], v[30:31], v[60:61], v[40:43]
    v_mfma_f32_16x16x16_bf16 v[44:47], v[30:31], v[62:63], v[44:47]
    s_waitcnt vmcnt(4)
    s_xor_b32 s59, s60, 0x80
    buffer_load_dwordx4 v[84:87], v12, s[12:15], s59 offen nt
    v_mfma_f32_16x16x16_bf16 v[40:43], v[32:33], v[64:65], v[40:43]
    v_mfma_f32_16x16x16_bf16 v[44:47], v[32:33], v[66:67], v[44:47]
    s_waitcnt vmcnt(4)
    s_xor_b32 s59, s60, 0x200
    buffer_load_dwordx4 v[88:91], v12, s[12:15], s59 offen nt
    v_mfma_f32_16x16x16_bf16 v[40:43], v[34:35], v[68:69], v[40:43]
    v_mfma_f32_16x16x16_bf16 v[44:47], v[34:35], v[70:71], v[44:47]
    s_waitcnt vmcnt(4)
    s_xor_b32 s59, s60, 0x280
    buffer_load_dwordx4 v[92:95], v12, s[12:15], s59 offen nt
    v_mfma_f32_16x16x16_bf16 v[40:43], v[36:37], v[72:73], v[40:43]
    v_mfma_f32_16x16x16_bf16 v[44:47], v[36:37], v[74:75], v[44:47]
    s_waitcnt vmcnt(4)
    s_xor_b32 s59, s60, 0x1000
    buffer_load_dwordx4 v[96:99], v12, s[12:15], s59 offen nt
    v_mfma_f32_16x16x16_bf16 v[40:43], v[38:39], v[76:77], v[40:43]
    v_mfma_f32_16x16x16_bf16 v[44:47], v[38:39], v[78:79], v[44:47]
    s_nop 7
    v_permlane16_swap_b32 v40, v44
    v_permlane16_swap_b32 v41, v45
    v_permlane16_swap_b32 v42, v46
    v_permlane16_swap_b32 v43, v47
    v_add_f32_dpp v40, v44, v40 row_ror:8 row_mask:0xf bank_mask:0xf
    v_add_f32_dpp v41, v45, v41 row_ror:8 row_mask:0xf bank_mask:0xf
    v_add_f32_dpp v42, v46, v42 row_ror:8 row_mask:0xf bank_mask:0xf
    v_add_f32_dpp v43, v47, v43 row_ror:8 row_mask:0xf bank_mask:0xf
    ds_write_b128 v5, v[40:43] offset:2048
    s_waitcnt lgkmcnt(0)
    s_barrier
    s_add_u32 s51, s51, 0x01010101
    s_and_b32 s52, s51, 0xff
    s_bfe_u32 s53, s51, 0x80008
    s_bfe_u32 s54, s51, 0x80010
    s_lshr_b32 s55, s51, 24
    s_waitcnt vmcnt(5)
    s_cbranch_vccnz L_wd8
    s_waitcnt vmcnt(4)
L_wd8:
    s_xor_b32 s59, s60, 0x1080
    buffer_load_dwordx4 v[100:103], v12, s[12:15], s59 offen nt
    s_waitcnt vmcnt(5)
    s_cbranch_vccnz L_wd9
    s_waitcnt vmcnt(4)
L_wd9:
    s_xor_b32 s59, s60, 0x1200
    buffer_load_dwordx4 v[104:107], v12, s[12:15], s59 offen nt
    s_waitcnt vmcnt(5)
    s_cbranch_vccnz L_wd10
    s_waitcnt vmcnt(4)
L_wd10:
    s_xor_b32 s59, s60, 0x1280
    buffer_load_dwordx4 v[108:111], v12, s[12:15], s59 offen nt
    s_waitcnt vmcnt(5)
    s_cbranch_vccnz L_wd11
    s_waitcnt vmcnt(4)
L_wd11:
    s_xor_b32 s59, s61, 0x0
    buffer_load_dwordx4 v[112:115], v10, s[16:19], s59 offen nt
    s_waitcnt vmcnt(5)
    s_cbranch_vccnz L_wd12
    s_waitcnt vmcnt(4)
L_wd12:
    s_xor_b32 s59, s61, 0x400
    buffer_load_dwordx4 v[116:119], v10, s[16:19], s59 offen nt
    s_waitcnt vmcnt(5)
    s_cbranch_vccnz L_wd13
    s_waitcnt vmcnt(4)
L_wd13:
    s_xor_b32 s59, s61, 0x800
    buffer_load_dwordx4 v[120:123], v10, s[16:19], s59 offen nt
    s_waitcnt vmcnt(5)
    s_cbranch_vccnz L_wd14
    s_waitcnt vmcnt(4)
L_wd14:
    s_xor_b32 s59, s61, 0xc00
    buffer_load_dwordx4 v[124:127], v10, s[16:19], s59 offen nt
    s_waitcnt vmcnt(5)
    s_cbranch_vccnz L_wd15
    s_waitcnt vmcnt(4)
L_wd15:
    s_xor_b32 s59, s61, 0x1000
    buffer_load_dwordx4 v[128:131], v10, s[16:19], s59 offen nt
    s_waitcnt vmcnt(5)
    s_cbranch_vccnz L_wd16
    s_waitcnt vmcnt(4)
L_wd16:
    s_xor_b32 s59, s61, 0x1400
    buffer_load_dwordx4 v[132:135], v10, s[16:19], s59 offen nt
    s_waitcnt vmcnt(5)
    s_cbranch_vccnz L_wd17
    s_waitcnt vmcnt(4)
L_wd17:
    s_xor_b32 s59, s61, 0x1800
    buffer_load_dwordx4 v[136:139], v10, s[16:19], s59 offen nt
    s_waitcnt vmcnt(5)
    s_cbranch_vccnz L_wd18
    s_waitcnt vmcnt(4)
L_wd18:
    s_xor_b32 s59, s61, 0x1c00
    buffer_load_dwordx4 v[140:143], v10, s[16:19], s59 offen nt
    s_lshl_b32 s57, s48, 7
    s_add_u32 s57, s57, 0x8000
    v_and_b32 v25, 31, v1
    v_lshlrev_b32 v25, 2, v25
    buffer_load_dword v25, v25, s[40:43], s57 offen sc1 nt
    buffer_load_dwordx4 v[208:211], v14, s[40:43], s62 offen sc1
    buffer_load_dwordx4 v[212:215], v14, s[40:43], s62 offen offset:2048 sc1
    buffer_load_dwordx4 v[216:219], v14, s[40:43], s97 offen sc1
    buffer_load_dwordx4 v[220:223], v14, s[40:43], s97 offen offset:2048 sc1
L_q0_out:
    s_barrier
    v_lshrrev_b32 v3, 5, v1
    s_lshl_b32 s57, s50, 1
    v_add_u32 v3, s57, v3
    v_and_b32 v4, 31, v1
    v_mul_u32_u24 v16, 272, v3
    v_lshl_add_u32 v16, v4, 3, v16
    v_mul_u32_u24 v20, 528, v3
    v_lshl_add_u32 v20, v4, 4, v20
    v_lshlrev_b32 v21, 5, v3
    v_lshrrev_b32 v4, 3, v4
    v_lshl_add_u32 v23, v3, 2, v4
    v_lshl_add_u32 v23, v23, 13, v7
    v_and_b32 v3, 7, v1
    v_lshrrev_b32 v4, 3, v1
    v_mul_u32_u24 v17, 272, v3
    v_lshl_add_u32 v17, v4, 4, v17
    v_mul_u32_u24 v18, 528, v3
    v_and_b32 v5, 0x30, v1
    s_mul_i32 s57, s50, 4224
    v_add3_u32 v18, v18, v5, s57
    s_lshl_b32 s57, s50, 3
    v_lshlrev_b32 v19, 5, v3
    v_add_u32 v19, s57, v19
    v_mov_b32 v22, s50
    s_andn2_b32 s57, 0x80, s94
    v_add_u32 v24, s57, v17
    s_and_b32 s57, s94, 0x80
    v_add_u32 v17, s57, v17
    s_waitcnt vmcnt(11)
    v_perm_b32 v144, v116, v112, s63
    v_perm_b32 v148, v116, v112, s64
    v_perm_b32 v152, v117, v113, s63
    v_perm_b32 v156, v117, v113, s64
    v_perm_b32 v160, v118, v114, s63
    v_perm_b32 v164, v118, v114, s64
    v_perm_b32 v168, v119, v115, s63
    v_perm_b32 v172, v119, v115, s64
    s_waitcnt vmcnt(9)
    v_perm_b32 v145, v124, v120, s63
    v_perm_b32 v149, v124, v120, s64
    v_perm_b32 v153, v125, v121, s63
    v_perm_b32 v157, v125, v121, s64
    v_perm_b32 v161, v126, v122, s63
    v_perm_b32 v165, v126, v122, s64
    v_perm_b32 v169, v127, v123, s63
    v_perm_b32 v173, v127, v123, s64
    s_waitcnt vmcnt(7)
    v_perm_b32 v146, v132, v128, s63
    v_perm_b32 v150, v132, v128, s64
    v_perm_b32 v154, v133, v129, s63
    v_perm_b32 v158, v133, v129, s64
    v_perm_b32 v162, v134, v130, s63
    v_perm_b32 v166, v134, v130, s64
    v_perm_b32 v170, v135, v131, s63
    v_perm_b32 v174, v135, v131, s64
    s_waitcnt vmcnt(5)
    v_perm_b32 v147, v140, v136, s63
    v_perm_b32 v151, v140, v136, s64
    v_perm_b32 v155, v141, v137, s63
    v_perm_b32 v159, v141, v137, s64
    v_perm_b32 v163, v142, v138, s63
    v_perm_b32 v167, v142, v138, s64
    v_perm_b32 v171, v143, v139, s63
    v_perm_b32 v175, v143, v139, s64
    s_waitcnt vmcnt(0)
    s_xor_b32 s95, s95, s51
    v_cmp_ne_u32 vcc, s95, v25
    s_mov_b32 s95, vcc_lo
    s_cmp_eq_u32 s95, 0
    s_cbranch_scc1 L_qchk
    s_cmp_lg_u32 s50, 0
    s_cbranch_scc1 L_qchk
    s_and_b32 s59, s49, 7
    s_lshl3_add_u32 s57, s48, s59
    s_xor_b32 s57, s57, 2
    s_lshr_b32 s58, s57, 2
    s_lshl_b32 s58, s58, 12
    s_and_b32 s57, s57, 3
    s_lshl_b32 s57, s57, 8
    s_add_u32 s58, s58, s57
    s_lshl_b32 s57, s66, 10
    s_add_u32 s58, s58, s57
    s_lshl1_add_u32 s58, s58, 0x500000
    v_lshrrev_b32 v3, 4, v1
    v_and_b32 v5, 15, v1
    v_lshlrev_b32 v6, 4, v5
    v_lshl_add_u32 v192, v3, 16, v6
    v_and_b32 v6, 0xffffff80, v192
    v_add_u32 v192, v6, v192
    v_and_b32 v6, 1, v1
    v_lshl_add_u32 v193, v3, 1, v6
    v_lshlrev_b32 v193, 8, v193
    v_lshrrev_b32 v5, 1, v5
    v_lshl_add_u32 v193, v5, 4, v193
    ds_read_b128 v[176:179], v193 offset:2048
    ds_read_b128 v[180:183], v193 offset:3072
    ds_read_b128 v[184:187], v193 offset:4096
    ds_read_b128 v[188:191], v193 offset:5120
    s_waitcnt lgkmcnt(0)
    v_pk_add_f32 v[176:177], v[176:177], v[180:181]
    v_pk_add_f32 v[178:179], v[178:179], v[182:183]
    v_pk_add_f32 v[184:185], v[184:185], v[188:189]
    v_pk_add_f32 v[186:187], v[186:187], v[190:191]
    v_pk_add_f32 v[176:177], v[176:177], v[184:185]
    v_pk_add_f32 v[178:179], v[178:179], v[186:187]
    v_bfi_b32 v176, v2, s52, v176
    v_bfi_b32 v177, v2, s53, v177
    v_bfi_b32 v178, v2, s54, v178
    v_bfi_b32 v179, v2, s55, v179
    s_mov_b32 exec_hi, 0
    buffer_store_dwordx4 v[176:179], v192, s[40:43], s58 offen sc1
    s_mov_b32 exec_hi, -1
L_qchk:
    v_xor_b32 v208, s52, v208
    v_xor_b32 v209, s53, v209
    v_xor_b32 v210, s54, v210
    v_xor_b32 v211, s55, v211
    v_xor_b32 v212, s52, v212
    v_xor_b32 v213, s53, v213
    v_xor_b32 v214, s54, v214
    v_xor_b32 v215, s55, v215
    v_xor_b32 v216, s52, v216
    v_xor_b32 v217, s53, v217
    v_xor_b32 v218, s54, v218
    v_xor_b32 v219, s55, v219
    v_xor_b32 v220, s52, v220
    v_xor_b32 v221, s53, v221
    v_xor_b32 v222, s54, v222
    v_xor_b32 v223, s55, v223
    v_or3_b32 v3, v208, v209, v210
    v_or3_b32 v3, v3, v211, v212
    v_or3_b32 v3, v3, v213, v214
    v_or3_b32 v3, v3, v215, v216
    v_or3_b32 v3, v3, v217, v218
    v_or3_b32 v3, v3, v219, v220
    v_or3_b32 v3, v3, v221, v222
    v_bitop3_b32 v3, v3, v223, v2 bitop3:0xa8
    v_cmp_ne_u32 vcc, 0, v3
    s_cbranch_vccz L_qok
    s_wqm_b64 exec, vcc
    s_sub_u32 s56, s56, 1
    s_cbranch_scc1 L_end
    buffer_load_dwordx4 v[208:211], v14, s[40:43], s62 offen sc1
    buffer_load_dwordx4 v[212:215], v14, s[40:43], s62 offen offset:2048 sc1
    buffer_load_dwordx4 v[216:219], v14, s[40:43], s97 offen sc1
    buffer_load_dwordx4 v[220:223], v14, s[40:43], s97 offen offset:2048 sc1
L_q1_out:
    s_waitcnt vmcnt(0)
    s_branch L_qchk
L_qok:
    s_mov_b64 exec, -1
    v_pk_add_f32 v[208:209], v[208:209], v[212:213]
    v_pk_add_f32 v[210:211], v[210:211], v[214:215]
    v_pk_add_f32 v[216:217], v[216:217], v[220:221]
    v_pk_add_f32 v[218:219], v[218:219], v[222:223]
    v_pk_add_f32 v[208:209], v[208:209], v[216:217]
    v_pk_add_f32 v[210:211], v[210:211], v[218:219]
    v_cvt_pk_bf16_f32 v4, v208, v209
    v_cvt_pk_bf16_f32 v5, v210, v211
    ds_write_b64 v16, v[4:5] offset:14336
    ds_write_b8 v22, v8 offset:0
    s_mov_b32 s57, 0x01010101
L_qi:
    s_sub_u32 s56, s56, 1
    s_cbranch_scc1 L_end
    ds_read_b32 v3, v9 offset:0
    ds_read_b128 v[224:227], v17 offset:14336
    ds_read_b128 v[228:231], v24 offset:14336
    s_waitcnt lgkmcnt(0)
    v_cmp_ne_u32 vcc, s57, v3
    s_cbranch_vccnz L_qi
    v_mfma_f32_16x16x32_bf16 v[232:235], v[80:83], v[224:227], 0
    v_mfma_f32_16x16x32_bf16 v[236:239], v[88:91], v[224:227], 0
    v_mfma_f32_16x16x32_bf16 v[240:243], v[96:99], v[224:227], 0
    v_mfma_f32_16x16x32_bf16 v[244:247], v[104:107], v[224:227], 0
    v_mfma_f32_16x16x32_bf16 v[232:235], v[84:87], v[228:231], v[232:235]
    v_mfma_f32_16x16x32_bf16 v[236:239], v[92:95], v[228:231], v[236:239]
    v_mfma_f32_16x16x32_bf16 v[240:243], v[100:103], v[228:231], v[240:243]
    v_mfma_f32_16x16x32_bf16 v[244:247], v[108:111], v[228:231], v[244:247]
    s_nop 5
    v_permlane32_swap_b32 v232, v236
    v_permlane32_swap_b32 v233, v237
    v_permlane32_swap_b32 v234, v238
    v_permlane32_swap_b32 v235, v239
    v_permlane32_swap_b32 v240, v244
    v_permlane32_swap_b32 v241, v245
    v_permlane32_swap_b32 v242, v246
    v_permlane32_swap_b32 v243, v247
    v_add_f32_dpp v28, v236, v232 row_ror:8 row_mask:0xf bank_mask:0x3
    v_add_f32_dpp v29, v237, v233 row_ror:8 row_mask:0xf bank_mask:0x3
    v_add_f32_dpp v30, v238, v234 row_ror:8 row_mask:0xf bank_mask:0x3
    v_add_f32_dpp v31, v239, v235 row_ror:8 row_mask:0xf bank_mask:0x3
    v_add_f32_dpp v28, v240, v244 row_ror:8 row_mask:0xf bank_mask:0xc
    v_add_f32_dpp v29, v241, v245 row_ror:8 row_mask:0xf bank_mask:0xc
    v_add_f32_dpp v30, v242, v246 row_ror:8 row_mask:0xf bank_mask:0xc
    v_add_f32_dpp v31, v243, v247 row_ror:8 row_mask:0xf bank_mask:0xc
    v_cvt_pk_bf16_f32 v28, 0, v28
    v_cvt_pk_bf16_f32 v29, 0, v29
    v_cvt_pk_bf16_f32 v30, 0, v30
    v_cvt_pk_bf16_f32 v31, 0, v31
    v_mul_f32 v28, 0x3db504f3, v28
    v_mul_f32 v29, 0x3db504f3, v29
    v_mul_f32 v30, 0x3db504f3, v30
    v_mul_f32 v31, 0x3db504f3, v31
    v_cvt_pk_bf16_f32 v28, 0, v28
    v_cvt_pk_bf16_f32 v29, 0, v29
    v_cvt_pk_bf16_f32 v30, 0, v30
    v_cvt_pk_bf16_f32 v31, 0, v31
    v_max3_f32 v32, v28, v29, v30
    v_max_f32 v32, v32, v31
    s_nop 1
    v_max_f32_dpp v32, v32, v32 row_ror:8 row_mask:0xf bank_mask:0xf
    v_mov_b32 v3, v32
    s_nop 1
    v_permlane16_swap_b32 v32, v3
    v_max_f32 v32, v32, v3
    v_mov_b32 v3, v32
    s_nop 1
    v_permlane32_swap_b32 v32, v3
    v_max_f32 v32, v32, v3
    s_mov_b32 s58, 0x3fb8aa3b
    v_sub_f32 v28, v28, v32
    v_sub_f32 v29, v29, v32
    v_sub_f32 v30, v30, v32
    v_sub_f32 v31, v31, v32
    v_mul_f32 v28, s58, v28
    v_mul_f32 v29, s58, v29
    v_mul_f32 v30, s58, v30
    v_mul_f32 v31, s58, v31
    v_exp_f32 v28, v28
    v_exp_f32 v29, v29
    v_exp_f32 v30, v30
    v_exp_f32 v31, v31
    v_cvt_pk_bf16_f32 v36, v28, v29
    v_cvt_pk_bf16_f32 v37, v30, v31
    v_add_f32 v33, v28, v29
    v_add_f32 v30, v30, v31
    v_mov_b32_dpp v38, v36 row_ror:8 row_mask:0xf bank_mask:0xf
    v_mov_b32_dpp v39, v37 row_ror:8 row_mask:0xf bank_mask:0xf
    v_add_f32 v33, v33, v30
    s_nop 1
    v_add_f32_dpp v33, v33, v33 row_ror:8 row_mask:0xf bank_mask:0xf
    v_mov_b32 v3, v33
    s_nop 1
    v_permlane16_swap_b32 v33, v3
    v_add_f32 v33, v33, v3
    v_mov_b32 v3, v33
    s_nop 1
    v_permlane32_swap_b32 v33, v3
    v_add_f32 v33, v33, v3
    v_mfma_f32_16x16x32_bf16 v[176:179], v[144:147], v[36:39], 0
    v_mfma_f32_16x16x32_bf16 v[180:183], v[148:151], v[36:39], 0
    v_mfma_f32_16x16x32_bf16 v[184:187], v[152:155], v[36:39], 0
    v_mfma_f32_16x16x32_bf16 v[188:191], v[156:159], v[36:39], 0
    v_mfma_f32_16x16x32_bf16 v[192:195], v[160:163], v[36:39], 0
    v_mfma_f32_16x16x32_bf16 v[196:199], v[164:167], v[36:39], 0
    v_mfma_f32_16x16x32_bf16 v[200:203], v[168:171], v[36:39], 0
    v_mfma_f32_16x16x32_bf16 v[204:207], v[172:175], v[36:39], 0
    s_mov_b32 exec_lo, 0x00ff00ff
    s_mov_b32 exec_hi, 0x00ff00ff
    ds_write_b128 v18, v[176:179] offset:16640
    ds_write_b128 v18, v[180:183] offset:16704
    ds_write_b128 v18, v[184:187] offset:16768
    ds_write_b128 v18, v[188:191] offset:16832
    ds_write_b128 v18, v[192:195] offset:16896
    ds_write_b128 v18, v[196:199] offset:16960
    ds_write_b128 v18, v[200:203] offset:17024
    ds_write_b128 v18, v[204:207] offset:17088
    ds_write_b64 v19, v[32:33] offset:256
    ds_write_b8 v22, v8 offset:4
    s_mov_b64 exec, -1
    s_lshl_b32 s63, s48, 18
    s_lshl_b32 s60, s49, 8
    s_add_u32 s63, s63, 0x100000
    s_add_u32 s59, s63, s60
    s_mov_b32 s60, 0x07060501
    s_mov_b32 s61, 0x07060502
    s_mov_b32 s62, 0x07060503
L_ox:
    s_sub_u32 s56, s56, 1
    s_cbranch_scc1 L_end
    ds_read_b32 v3, v9 offset:4
    ds_read_b128 v[28:31], v21 offset:256
    ds_read_b128 v[32:35], v21 offset:272
    ds_read_b128 v[208:211], v20 offset:16640
    ds_read_b128 v[212:215], v20 offset:20864
    ds_read_b128 v[216:219], v20 offset:25088
    ds_read_b128 v[220:223], v20 offset:29312
    s_waitcnt lgkmcnt(0)
    v_cmp_ne_u32 vcc, s57, v3
    s_cbranch_vccnz L_ox
    v_max3_f32 v36, v28, v30, v32
    v_max_f32 v36, v36, v34
    v_sub_f32 v28, v28, v36
    v_sub_f32 v30, v30, v36
    v_sub_f32 v32, v32, v36
    v_sub_f32 v34, v34, v36
    v_mul_f32 v28, s58, v28
    v_mul_f32 v30, s58, v30
    v_mul_f32 v32, s58, v32
    v_mul_f32 v34, s58, v34
    v_exp_f32 v28, v28
    v_exp_f32 v30, v30
    v_exp_f32 v32, v32
    v_exp_f32 v34, v34
    v_mul_f32 v37, v28, v29
    v_fmac_f32 v37, v30, v31
    v_fmac_f32 v37, v32, v33
    v_fmac_f32 v37, v34, v35
    v_log_f32 v38, v37
    v_rcp_f32 v37, v37
    v_pk_mul_f32 v[208:209], v[28:29], v[208:209] op_sel:[0,0] op_sel_hi:[0,1]
    v_pk_mul_f32 v[210:211], v[28:29], v[210:211] op_sel:[0,0] op_sel_hi:[0,1]
    v_fmac_f32 v38, s58, v36
    v_pk_fma_f32 v[208:209], v[30:31], v[212:213], v[208:209] op_sel:[0,0,0] op_sel_hi:[0,1,1]
    v_pk_fma_f32 v[210:211], v[30:31], v[214:215], v[210:211] op_sel:[0,0,0] op_sel_hi:[0,1,1]
    v_pk_fma_f32 v[208:209], v[32:33], v[216:217], v[208:209] op_sel:[0,0,0] op_sel_hi:[0,1,1]
    v_pk_fma_f32 v[210:211], v[32:33], v[218:219], v[210:211] op_sel:[0,0,0] op_sel_hi:[0,1,1]
    v_pk_fma_f32 v[208:209], v[34:35], v[220:221], v[208:209] op_sel:[0,0,0] op_sel_hi:[0,1,1]
    v_pk_fma_f32 v[210:211], v[34:35], v[222:223], v[210:211] op_sel:[0,0,0] op_sel_hi:[0,1,1]
    v_pk_mul_f32 v[208:209], v[36:37], v[208:209] op_sel:[1,0] op_sel_hi:[1,1]
    v_pk_mul_f32 v[210:211], v[36:37], v[210:211] op_sel:[1,0] op_sel_hi:[1,1]
    v_bfi_b32 v208, v2, s52, v208
    v_perm_b32 v209, v209, v38, s60
    v_perm_b32 v210, v210, v38, s61
    v_perm_b32 v211, v211, v38, s62
    s_cmp_eq_u32 s95, 0
    s_cbranch_scc1 L_po_near
    buffer_store_dwordx4 v[208:211], v23, s[40:43], s59 offen sc1
    s_branch L_po_out
L_po_near:
    buffer_store_dwordx4 v[208:211], v23, s[40:43], s59 offen
L_po_out:
    s_cmp_ge_u32 s50, 2
    s_cbranch_scc1 L_H
    s_cmp_eq_u32 s50, 1
    s_cbranch_scc1 L_HP
    s_lshl_b32 s59, s49, 13
    s_add_u32 s59, s59, s63
    s_mov_b32 s61, 0x0c04000c
    s_add_u32 s97, s59, 4096
    s_and_b32 s60, s96, 3
    s_lshl_b32 s60, s60, 5
    s_add_u32 s60, s60, s49
    s_lshr_b32 s57, s96, 2
    s_lshl1_add_u32 s60, s60, s57
    s_lshl_b32 s60, s60, 7
    s_add_u32 s60, s60, 0x30000
    v_mov_b32 v3, s95
    ds_write_b32 v9, v3 offset:20
    s_lshl_b32 s62, s49, 10
    s_add_u32 s62, s62, 0x30000
    s_and_b32 s63, s51, 0xffff
    s_mov_b32 s64, 0xffff
    s_lshr_b32 s57, s60, 9
    v_and_b32 v3, 15, v1
    v_lshrrev_b32 v4, 4, v1
    v_lshlrev_b32 v27, 1, v3
    v_lshl_add_u32 v27, v4, 7, v27
    v_mov_b32 v26, 0x101
L_to:
    s_sub_u32 s56, s56, 1
    s_cbranch_scc1 L_end
    ds_read_u8 v3, v9 offset:24
    s_waitcnt lgkmcnt(0)
    v_cmp_ne_u32 vcc, 1, v3
    s_cbranch_vccnz L_to
L_og:
    s_sub_u32 s56, s56, 1
    s_cbranch_scc1 L_end
    buffer_load_dwordx4 v[48:51], v14, s[40:43], s59 offen sc1 nt
    buffer_load_dwordx4 v[52:55], v14, s[40:43], s59 offen offset:2048 sc1 nt
    buffer_load_dwordx4 v[56:59], v14, s[40:43], s97 offen sc1 nt
    buffer_load_dwordx4 v[60:63], v14, s[40:43], s97 offen offset:2048 sc1 nt
L_ogc:
    s_waitcnt vmcnt(0)
    v_xor_b32 v48, s52, v48
    v_perm_b32 v28, v50, v49, s61
    v_lshl_or_b32 v28, v51, 24, v28
    v_xor_b32 v52, s52, v52
    v_perm_b32 v29, v54, v53, s61
    v_lshl_or_b32 v29, v55, 24, v29
    v_xor_b32 v56, s52, v56
    v_perm_b32 v30, v58, v57, s61
    v_lshl_or_b32 v30, v59, 24, v30
    v_xor_b32 v60, s52, v60
    v_perm_b32 v31, v62, v61, s61
    v_lshl_or_b32 v31, v63, 24, v31
    v_or3_b32 v3, v48, v52, v56
    v_or_b32 v3, v3, v60
    v_and_b32 v3, v2, v3
    v_cmp_ne_u32 vcc, 0, v3
    v_max3_f32 v36, v28, v29, v30
    v_max_f32 v36, v36, v31
    s_wqm_b64 exec, vcc
    s_cbranch_vccnz L_og
    s_mov_b64 exec, -1
    v_max_f32_dpp v36, v36, v36 row_ror:8 row_mask:0xf bank_mask:0xf
    v_mov_b32 v3, v36
    s_nop 1
    v_permlane16_swap_b32 v36, v3
    v_max_f32 v36, v36, v3
    v_mov_b32 v3, v36
    s_nop 1
    v_permlane32_swap_b32 v36, v3
    v_max_f32 v36, v36, v3
    v_sub_f32 v28, v28, v36
    v_sub_f32 v29, v29, v36
    v_sub_f32 v30, v30, v36
    v_sub_f32 v31, v31, v36
    v_exp_f32 v28, v28
    v_exp_f32 v29, v29
    v_exp_f32 v30, v30
    v_exp_f32 v31, v31
    v_pk_mul_f32 v[40:41], v[28:29], v[48:49] op_sel:[0,0] op_sel_hi:[0,1]
    v_pk_mul_f32 v[42:43], v[28:29], v[50:51] op_sel:[0,0] op_sel_hi:[0,1]
    v_add_f32 v36, v28, v29
    v_add_f32 v37, v30, v31
    v_pk_fma_f32 v[40:41], v[28:29], v[52:53], v[40:41] op_sel:[1,0,0] op_sel_hi:[1,1,1]
    v_pk_fma_f32 v[42:43], v[28:29], v[54:55], v[42:43] op_sel:[1,0,0] op_sel_hi:[1,1,1]
    v_add_f32 v36, v36, v37
    v_pk_fma_f32 v[40:41], v[30:31], v[56:57], v[40:41] op_sel:[0,0,0] op_sel_hi:[0,1,1]
    v_pk_fma_f32 v[42:43], v[30:31], v[58:59], v[42:43] op_sel:[0,0,0] op_sel_hi:[0,1,1]
    v_add_f32_dpp v36, v36, v36 row_ror:8 row_mask:0xf bank_mask:0xf
    v_pk_fma_f32 v[40:41], v[30:31], v[60:61], v[40:41] op_sel:[1,0,0] op_sel_hi:[1,1,1]
    v_pk_fma_f32 v[42:43], v[30:31], v[62:63], v[42:43] op_sel:[1,0,0] op_sel_hi:[1,1,1]
    v_mov_b32 v3, v36
    s_nop 1
    v_permlane16_swap_b32 v36, v3
    v_add_f32 v36, v36, v3
    v_mov_b32 v3, v36
    s_nop 1
    v_permlane32_swap_b32 v36, v3
    v_add_f32 v36, v36, v3
    v_rcp_f32 v36, v36
    v_permlane32_swap_b32 v40, v42
    v_permlane32_swap_b32 v41, v43
    v_add_f32 v40, v40, v42
    v_add_f32 v41, v41, v43
    s_nop 1
    v_permlane16_swap_b32 v40, v41
    v_add_f32 v40, v40, v41
    s_nop 1
    v_add_f32_dpp v40, v40, v40 row_ror:8 row_mask:0xf bank_mask:0xf
    v_mul_f32 v40, v36, v40
    v_cvt_pk_bf16_f32 v40, 0, v40
    v_or_b32 v40, s63, v40
    v_mov_b32 v41, v40
    s_nop 1
    v_permlane16_swap_b32 v40, v41
    v_mov_b32 v42, v40
    v_mov_b32 v43, v41
    s_nop 0
    v_permlane32_swap_b32 v40, v42
    v_permlane32_swap_b32 v41, v43
    s_mov_b64 exec, 0xff
    buffer_store_dwordx4 v[40:43], v13, s[40:43], s60 offen sc1
    s_mov_b64 exec, -1
L_t2:
    s_sub_u32 s56, s56, 1
    s_cbranch_scc1 L_end
    ds_read_u8 v3, v9 offset:28
    s_waitcnt lgkmcnt(0)
    v_cmp_ne_u32 vcc, 1, v3
    s_cbranch_vccnz L_t2
L_o2:
    s_sub_u32 s56, s56, 1
    s_cbranch_scc1 L_end
    buffer_load_dwordx4 v[44:47], v13, s[40:43], s62 offen sc1
    s_waitcnt vmcnt(0)
    v_xor_b32 v44, s63, v44
    v_xor_b32 v45, s63, v45
    v_xor_b32 v46, s63, v46
    v_xor_b32 v47, s63, v47
    v_or3_b32 v3, v44, v45, v46
    v_or_b32 v3, v3, v47
    v_and_b32 v3, s64, v3
    v_cmp_ne_u32 vcc, 0, v3
    s_cbranch_vccnz L_o2
    ds_write_b16_d16_hi v27, v44 offset:512
    ds_write_b16_d16_hi v27, v45 offset:544
    ds_write_b16_d16_hi v27, v46 offset:576
    ds_write_b16_d16_hi v27, v47 offset:608
    ds_write_b16 v9, v26 offset:12
    s_waitcnt lgkmcnt(0)
    s_endpgm
L_HP:
    s_and_b32 s59, s49, 7
    s_add_u32 s61, s48, 3
    s_and_b32 s61, s61, 7
    s_min_u32 s61, s61, 6
    s_add_u32 s63, s59, 2
    s_lshr_b32 s63, s63, 2
    s_sub_u32 s63, s59, s63
    s_cmp_ge_u32 s63, s61
    s_addc_u32 s63, s63, 0
    s_and_b32 s60, s49, 3
    s_cmp_eq_u32 s60, 1
    s_cselect_b32 s63, s61, s63
    s_cselect_b32 s61, 8, 0
    s_mul_i32 s60, s48, 7
    s_add_u32 s63, s63, s60
    s_and_b32 s64, s66, 1
    s_lshr_b32 s67, s66, 1
    s_lshr_b32 s59, s59, 2
    s_cmp_eq_u32 s61, 8
    s_cselect_b32 s64, s59, s64
    s_cselect_b32 s67, s66, s67
    s_lshl1_add_u32 s59, s67, s64
    s_mul_i32 s59, s59, 28672
    s_lshl_b32 s63, s63, 9
    s_add_u32 s63, s63, s59
    s_add_u32 s63, s63, 0x40000
    v_mov_b32 v26, v13
    v_and_b32 v6, 1, v1
    v_lshlrev_b32 v27, 3, v6
    v_bfe_u32 v5, v1, 1, 1
    v_lshl_add_u32 v27, v5, 8, v27
    v_bfe_u32 v5, v1, 2, 3
    v_lshl_add_u32 v27, v5, 4, v27
    s_mov_b32 s57, 0x01010101
L_hp:
    s_sub_u32 s56, s56, 1
    s_cbranch_scc1 L_end
    ds_read_b32 v3, v9 offset:8
    ds_read2st64_b64 v[48:51], v27 offset0:12 offset1:13
    ds_read2st64_b64 v[52:55], v27 offset0:14 offset1:15
    ds_read2st64_b64 v[56:59], v27 offset0:16 offset1:17
    ds_read2st64_b64 v[60:63], v27 offset0:18 offset1:19
    s_waitcnt lgkmcnt(0)
    v_cmp_ne_u32 vcc, s57, v3
    s_cbranch_vccnz L_hp
    v_pk_add_f32 v[48:49], v[48:49], v[52:53]
    v_pk_add_f32 v[50:51], v[50:51], v[54:55]
    v_pk_add_f32 v[56:57], v[56:57], v[60:61]
    v_pk_add_f32 v[58:59], v[58:59], v[62:63]
    v_pk_add_f32 v[48:49], v[48:49], v[56:57]
    v_pk_add_f32 v[50:51], v[50:51], v[58:59]
    v_bfi_b32 v48, v2, s52, v48
    v_bfi_b32 v49, v2, s53, v49
    v_bfi_b32 v50, v2, s54, v50
    v_bfi_b32 v51, v2, s55, v51
    s_mov_b32 exec_hi, 0
    buffer_store_dwordx4 v[48:51], v26, s[40:43], s63 offen sc1
    s_mov_b32 exec_hi, -1
    s_lshl_b32 s57, s48, 15
    s_lshl_b32 s59, s49, 10
    s_add_u32 s57, s57, s59
    s_add_u32 s57, s57, 0x80000
    buffer_load_dwordx4 v[144:147], v13, s[40:43], s57 offen sc1
    s_waitcnt vmcnt(0)
    s_waitcnt lgkmcnt(0)
    s_endpgm
L_H:
    s_lshl1_add_u32 s59, s49, s50
    s_mul_i32 s59, s59, 448
    s_add_u32 s59, s59, 0x3fc80
    s_add_u32 s60, s59, 114688
    s_add_u32 s61, s59, 28672
    s_add_u32 s62, s60, 28672
    v_and_b32 v3, 31, v1
    v_min_u32 v3, 27, v3
    v_lshrrev_b32 v5, 5, v1
    v_mul_u32_u24 v26, 57344, v5
    v_lshl_add_u32 v26, v3, 4, v26
    s_lshl1_add_u32 s57, s49, s50
    s_mul_i32 s57, s57, 28
    s_sub_u32 s57, s57, 56
    v_add_u32 v4, s57, v3
    v_lshrrev_b32 v4, 5, v4
    s_mov_b32 s68, 0x8080808
    s_mov_b32 s69, 0x8080c
    v_lshrrev_b64 v[6:7], v4, s[68:69]
    v_bfe_i32 v6, v6, 0, 1
    v_mov_b32 v7, 0x7f000000
    v_bfi_b32 v25, v6, v26, v7
    v_and_b32 v28, s52, v6
    v_and_b32 v29, s53, v6
    v_and_b32 v30, s54, v6
    v_and_b32 v31, s55, v6
    v_cmp_ne_u32 s[68:69], 0, v6
    v_cmp_lt_u32 vcc, 13, v3
    v_add_u32 v4, 114, v3
    s_nop 0
    v_cndmask_b32 v4, v3, v4, vcc
    v_and_b32 v3, 1, v3
    v_and_b32 v4, -2, v4
    v_lshl_add_u32 v27, v3, 6, v4
    v_lshl_add_u32 v27, v5, 4, v27
    s_lshl_b32 s57, s50, 8
    v_add_u32 v27, s57, v27
L_th:
    s_sub_u32 s56, s56, 1
    s_cbranch_scc1 L_end
    ds_read_u8 v3, v22 offset:24
    s_waitcnt lgkmcnt(0)
    v_cmp_ne_u32 vcc, 1, v3
    s_cbranch_vccnz L_th
    s_cmp_lg_u64 s[68:69], 0
    s_cbranch_scc1 L_hg
L_hs:
    s_sub_u32 s56, s56, 1
    s_cbranch_scc1 L_end
    buffer_load_dwordx4 v[48:51], v26, s[40:43], s59 offen sc1
    buffer_load_dwordx4 v[56:59], v26, s[40:43], s61 offen sc1
    s_waitcnt vmcnt(0)
    v_xor_b32 v48, s52, v48
    v_xor_b32 v49, s53, v49
    v_xor_b32 v50, s54, v50
    v_xor_b32 v51, s55, v51
    v_xor_b32 v56, s52, v56
    v_xor_b32 v57, s53, v57
    v_xor_b32 v58, s54, v58
    v_xor_b32 v59, s55, v59
    v_or3_b32 v3, v48, v49, v50
    v_or3_b32 v4, v56, v57, v58
    v_or3_b32 v3, v3, v51, v59
    v_bitop3_b32 v3, v3, v4, v2 bitop3:0xa8
    v_cmp_ne_u32 vcc, 0, v3
    s_wqm_b64 exec, vcc
    s_cbranch_vccnz L_hs
    s_mov_b64 exec, -1
    s_branch L_hc
L_hg:
    s_sub_u32 s56, s56, 1
    s_cbranch_scc1 L_end
    buffer_load_dwordx4 v[48:51], v26, s[40:43], s59 offen sc1
    buffer_load_dwordx4 v[52:55], v25, s[40:43], s60 offen sc1
    buffer_load_dwordx4 v[56:59], v26, s[40:43], s61 offen sc1
    buffer_load_dwordx4 v[60:63], v25, s[40:43], s62 offen sc1
    s_waitcnt vmcnt(0)
    v_xor_b32 v48, s52, v48
    v_xor_b32 v49, s53, v49
    v_xor_b32 v50, s54, v50
    v_xor_b32 v51, s55, v51
    v_xor_b32 v52, v28, v52
    v_xor_b32 v53, v29, v53
    v_xor_b32 v54, v30, v54
    v_xor_b32 v55, v31, v55
    v_xor_b32 v56, s52, v56
    v_xor_b32 v57, s53, v57
    v_xor_b32 v58, s54, v58
    v_xor_b32 v59, s55, v59
    v_xor_b32 v60, v28, v60
    v_xor_b32 v61, v29, v61
    v_xor_b32 v62, v30, v62
    v_xor_b32 v63, v31, v63
    v_or3_b32 v3, v48, v49, v50
    v_or3_b32 v3, v3, v51, v52
    v_or3_b32 v3, v3, v53, v54
    v_or3_b32 v3, v3, v55, v56
    v_or3_b32 v3, v3, v57, v58
    v_or3_b32 v3, v3, v59, v60
    v_or3_b32 v3, v3, v61, v62
    v_bitop3_b32 v3, v3, v63, v2 bitop3:0xa8
    v_cmp_ne_u32 vcc, 0, v3
    s_wqm_b64 exec, vcc
    s_cbranch_vccnz L_hg
    s_mov_b64 exec, -1
    v_pk_add_f32 v[48:49], v[48:49], v[52:53]
    v_pk_add_f32 v[50:51], v[50:51], v[54:55]
    v_pk_add_f32 v[56:57], v[56:57], v[60:61]
    v_pk_add_f32 v[58:59], v[58:59], v[62:63]
    s_nop 1
L_hc:
    v_permlane32_swap_b32 v48, v50
    v_permlane32_swap_b32 v49, v51
    v_permlane32_swap_b32 v56, v58
    v_permlane32_swap_b32 v57, v59
    v_pk_add_f32 v[48:49], v[48:49], v[50:51]
    v_pk_add_f32 v[56:57], v[56:57], v[58:59]
    v_cvt_pk_bf16_f32 v48, 0, v48
    v_cvt_pk_bf16_f32 v49, 0, v49
    v_cvt_pk_bf16_f32 v56, 0, v56
    v_cvt_pk_bf16_f32 v57, 0, v57
    v_mul_f32 v48, 0xbfb8aa3b, v48
    v_mul_f32 v49, 0xbfb8aa3b, v49
    v_exp_f32 v48, v48
    v_exp_f32 v49, v49
    v_add_f32 v48, 1.0, v48
    v_add_f32 v49, 1.0, v49
    v_rcp_f32 v48, v48
    v_rcp_f32 v49, v49
    v_cvt_pk_bf16_f32 v48, 0, v48
    v_cvt_pk_bf16_f32 v49, 0, v49
    v_mul_f32 v48, v48, v56
    v_mul_f32 v49, v49, v57
    v_cvt_pk_bf16_f32 v4, v48, v49
    ds_write_b16 v27, v4 offset:512
    ds_write_b16_d16_hi v27, v4 offset:544
    ds_write_b8 v22, v8 offset:12
    s_waitcnt lgkmcnt(0)
    s_endpgm
L_F:
    s_load_dwordx2 s[36:37], s[0:1], 72
    s_load_dwordx2 s[20:21], s[0:1], 48
    s_load_dwordx2 s[24:25], s[0:1], 56
    s_load_dwordx2 s[28:29], s[0:1], 32
    s_load_dwordx2 s[32:33], s[0:1], 64
    s_load_dwordx2 s[44:45], s[0:1], 80
    s_mov_b32 s38, 0x800
    s_mov_b32 s39, 0x20000
    v_and_b32 v3, 31, v1
    v_lshlrev_b32 v253, 4, v3
    v_lshrrev_b32 v4, 5, v1
    v_lshl_add_u32 v254, v4, 11, v253
    v_mov_b32 v8, 1
    v_mov_b32 v9, 0
    v_mov_b32 v2, 0xff
    s_waitcnt lgkmcnt(0)
    s_load_dword s51, s[40:41], 0
    s_mov_b32 s42, 0x10000000
    s_mov_b32 s43, 0x20000
    s_mov_b32 s22, 0x700000
    s_mov_b32 s23, 0x20000
    s_mov_b32 s26, 0x700000
    s_mov_b32 s27, 0x20000
    s_mov_b32 s30, 0x800000
    s_mov_b32 s31, 0x20000
    s_mov_b32 s34, 0x700000
    s_mov_b32 s35, 0x20000
    s_mov_b32 s46, 0x1000
    s_mov_b32 s47, 0x20000
    v_lshlrev_b32 v3, 2, v1
    v_and_b32 v3, 31, v3
    ds_write_b32 v3, v9
    s_mov_b32 s56, 100000
    s_lshl_b32 s57, s50, 2
    v_lshlrev_b32 v234, 4, v4
    v_add_u32 v235, s57, v234
    s_and_b32 s59, s49, 7
    s_add_u32 s61, s48, 3
    s_and_b32 s61, s61, 7
    s_min_u32 s61, s61, 6
    s_add_u32 s63, s59, 2
    s_lshr_b32 s63, s63, 2
    s_sub_u32 s63, s59, s63
    s_cmp_ge_u32 s63, s61
    s_addc_u32 s63, s63, 0
    s_and_b32 s60, s49, 3
    s_cmp_eq_u32 s60, 1
    s_cselect_b32 s63, s61, s63
    s_cselect_b32 s61, 8, 0
    s_mul_i32 s60, s48, 7
    s_add_u32 s63, s63, s60
    s_and_b32 s64, s66, 1
    s_lshr_b32 s67, s66, 1
    s_lshr_b32 s59, s59, 2
    s_cmp_eq_u32 s61, 8
    s_cselect_b32 s64, s59, s64
    s_cselect_b32 s67, s66, s67
    s_cmp_eq_u32 s64, 1
    s_cselect_b64 s[20:21], s[24:25], s[20:21]
    s_cmp_eq_u32 s61, 8
    s_cselect_b32 s67, 0x7f000000, 0
    s_mov_b32 s64, 0
    s_mov_b32 s94, 1734656
    s_bitcmp1_b32 s66, 0
    s_cselect_b32 s94, -1935360, s94
    s_xor_b32 s97, s58, 4
    s_lshl_b32 s97, s97, 7
    s_lshr_b32 s59, s50, 1
    v_mov_b32 v244, s59
    s_add_u32 s61, s61, s59
    v_mov_b32 v247, s61
    s_add_u32 s60, s59, 8
    s_cmp_lt_u32 s48, 2
    s_cselect_b32 s60, s60, s59
    v_mov_b32 v238, s60
    v_mul_u32_u24 v11, 7168, v6
    v_add_u32 v11, v11, v7
    v_add_u32 v246, s67, v11
    v_add_u32 v11, s64, v11
    s_mul_i32 s58, s58, 458752
    s_lshl_b32 s59, s63, 7
    s_add_u32 s58, s58, s59
    s_and_b32 s59, s49, 7
    s_lshl3_add_u32 s57, s48, s59
    s_xor_b32 s57, s57, 2
    s_lshr_b32 s62, s57, 2
    s_lshl_b32 s62, s62, 12
    s_and_b32 s57, s57, 3
    s_lshl_b32 s57, s57, 8
    s_add_u32 s62, s62, s57
    s_lshl_b32 s57, s66, 10
    s_add_u32 s62, s62, s57
    s_lshl1_add_u32 s62, s62, 0x500000
    s_lshr_b32 s57, s62, 12
    s_lshl_b32 s65, s48, 3
    s_lshr_b32 s57, s49, 2
    s_add_u32 s65, s65, s57
    s_and_b32 s64, s49, 3
    s_and_b32 s67, s50, 1
    s_lshl_b32 s59, s64, 1
    s_add_u32 s59, s59, s67
    s_lshl_b32 s59, s59, 8
    s_lshl_b32 s61, s65, 1
    s_lshr_b32 s57, s50, 1
    s_add_u32 s61, s61, s57
    s_lshl2_add_u32 s61, s49, s50
    s_lshl_b32 s59, s48, 8
    s_lshr_b32 s60, s61, 2
    s_lshl_b32 s60, s60, 18
    s_and_b32 s57, s61, 3
    s_lshl_b32 s57, s57, 12
    s_add_u32 s60, s60, s57
    s_add_u32 s60, s60, s59
    s_mul_i32 s61, s61, 57344
    s_add_u32 s61, s61, s59
    v_lshrrev_b32 v3, 4, v1
    v_lshl_add_u32 v6, v5, 7, v7
    v_lshl_add_u32 v12, v3, 14, v6
    v_lshl_add_u32 v13, v3, 11, v6
    s_lshl_b32 s57, s50, 10
    v_lshlrev_b32 v236, 4, v1
    v_add_u32 v236, s57, v236
    v_mov_b32 v240, s50
    v_and_b32 v5, 15, v1
    v_lshlrev_b32 v6, 4, v5
    v_lshl_add_u32 v239, v3, 16, v6
    v_and_b32 v6, 0xffffff80, v239
    v_add_u32 v239, v6, v239
    v_and_b32 v6, 1, v1
    v_lshl_add_u32 v237, v3, 1, v6
    v_lshlrev_b32 v237, 8, v237
    v_lshrrev_b32 v5, 1, v5
    v_lshl_add_u32 v237, v5, 4, v237
    v_lshlrev_b32 v255, 8, v6
    v_lshl_add_u32 v255, v4, 9, v255
    v_bfe_u32 v5, v1, 1, 4
    v_lshl_add_u32 v255, v5, 4, v255
    v_lshrrev_b32 v4, 2, v1
    v_and_b32 v5, 3, v1
    v_lshlrev_b32 v241, 4, v5
    v_lshl_add_u32 v241, v4, 11, v241
    v_lshrrev_b32 v4, 3, v1
    v_lshlrev_b32 v243, 7, v240
    v_lshl_add_u32 v243, v4, 4, v243
    v_lshlrev_b32 v242, 4, v1
    v_lshlrev_b32 v245, 3, v5
    v_lshl_add_u32 v245, v3, 1, v245
    s_lshl_b32 s57, s48, 15
    s_add_u32 s57, s57, 0x80000
    s_lshl_b32 s59, s49, 6
    s_add_u32 s68, s57, s59
    s_andn2_b32 s59, s49, 1
    s_lshl_b32 s59, s59, 10
    s_add_u32 s69, s57, s59
    s_and_b32 s67, s49, 1
    s_xor_b32 s67, s67, 0
    s_bfe_u32 s59, s49, 0x10003
    s_lshl_b32 s57, s48, 1
    s_add_u32 s57, s57, s59
    s_and_b32 s59, s49, 16
    s_add_u32 s57, s57, s59
    s_lshl_b32 s57, s57, 7
    s_and_b32 s59, s49, 6
    s_lshl_b32 s59, s59, 4
    s_add_u32 s66, s57, s59
    v_bfe_u32 v3, v1, 2, 1
    v_mul_u32_u24 v3, 0x202, v3
    v_add_u32 v3, 0x0c0c0100, v3
    v_lshlrev_b32 v4, 4, v1
    v_alignbit_b32 v3, v3, v3, v4
    v_and_b32 v4, 2, v1
    v_cmp_eq_u32 vcc, 0, v4
    v_mov_b32 v4, 0x0c0c0c0c
    s_nop 0
    v_cndmask_b32 v14, v4, v3, vcc
    v_cndmask_b32 v15, v3, v4, vcc
    v_lshlrev_b32 v4, 4, v1
    v_mov_b32 v3, 0x0c0c0100
    v_alignbit_b32 v5, v3, v3, v4
    v_mov_b32 v3, 0x0c0c0302
    v_alignbit_b32 v6, v3, v3, v4
    v_bfe_u32 v7, v1, 1, 2
    v_mov_b32 v4, 0x0c0c0c0c
    v_cmp_eq_u32 vcc, 0, v7
    s_nop 1
    v_cndmask_b32 v56, v4, v5, vcc
    v_cndmask_b32 v60, v4, v6, vcc
    v_cmp_eq_u32 vcc, 1, v7
    s_nop 1
    v_cndmask_b32 v57, v4, v5, vcc
    v_cndmask_b32 v61, v4, v6, vcc
    v_cmp_eq_u32 vcc, 2, v7
    s_nop 1
    v_cndmask_b32 v58, v4, v5, vcc
    v_cndmask_b32 v62, v4, v6, vcc
    v_cmp_eq_u32 vcc, 3, v7
    s_nop 1
    v_cndmask_b32 v59, v4, v5, vcc
    v_cndmask_b32 v63, v4, v6, vcc
    s_lshl_b32 s59, s50, 9
    s_waitcnt lgkmcnt(0)
    buffer_load_dwordx4 v[64:67], v254, s[4:7], s59 offen
    buffer_load_dwordx4 v[68:71], v253, s[36:39], s59 offen
    buffer_load_dwordx4 v[208:211], v10, s[4:7], s97 offen
    buffer_load_dwordx4 v[212:215], v10, s[4:7], s97 offen offset:16
    s_add_u32 s51, s51, 0x01010101
    s_and_b32 s52, s51, 0xff
    s_bfe_u32 s53, s51, 0x80008
    s_bfe_u32 s54, s51, 0x80010
    s_lshr_b32 s55, s51, 24
    s_cmp_lg_u32 s50, 0
    s_cbranch_scc1 L_nodie
    s_lshl_b32 s57, s48, 5
    s_add_u32 s57, s57, s49
    s_lshl_b32 s57, s57, 2
    s_add_u32 s57, s57, 0x8000
    s_xor_b32 s96, s95, s51
    v_mov_b32 v3, s96
    s_mov_b64 exec, 1
    buffer_store_dword v3, v9, s[40:43], s57 offen
    s_mov_b64 exec, -1
L_nodie:
    s_barrier
    s_waitcnt vmcnt(0)
    s_cmp_lg_u32 s50, 0
    s_cbranch_scc1 L_noq
    ds_read_b128 v[80:83], v237 offset:2048
    ds_read_b128 v[84:87], v237 offset:3072
    ds_read_b128 v[88:91], v237 offset:4096
    ds_read_b128 v[92:95], v237 offset:5120
    s_waitcnt lgkmcnt(0)
    v_pk_add_f32 v[80:81], v[80:81], v[84:85]
    v_pk_add_f32 v[82:83], v[82:83], v[86:87]
    v_pk_add_f32 v[88:89], v[88:89], v[92:93]
    v_pk_add_f32 v[90:91], v[90:91], v[94:95]
    v_pk_add_f32 v[80:81], v[80:81], v[88:89]
    v_pk_add_f32 v[82:83], v[82:83], v[90:91]
    v_bfi_b32 v248, v2, s52, v80
    v_bfi_b32 v249, v2, s53, v81
    v_bfi_b32 v250, v2, s54, v82
    v_bfi_b32 v251, v2, s55, v83
    s_mov_b32 s57, 0xffff
    s_not_b32 s96, s57
    s_bitcmp1_b32 s48, 0
    s_cselect_b32 s96, s57, s96
    s_mov_b32 exec_lo, s96
    s_mov_b32 exec_hi, 0
    buffer_store_dwordx4 v[248:251], v239, s[40:43], s62 offen sc1
    s_not_b32 exec_lo, s96
    buffer_store_dwordx4 v[248:251], v239, s[40:43], s62 offen
    s_mov_b64 exec, -1
L_noq:
    ds_read_b128 v[16:19], v236 offset:33536
    ds_read_b128 v[20:23], v236 offset:37632
    s_waitcnt lgkmcnt(0)
    v_perm_b32 v24, v16, v16, v14
    v_perm_b32 v25, v16, v16, v15
    v_perm_b32 v26, v17, v17, v14
    v_perm_b32 v27, v17, v17, v15
    v_perm_b32 v28, v18, v18, v14
    v_perm_b32 v29, v18, v18, v15
    v_perm_b32 v30, v19, v19, v14
    v_perm_b32 v31, v19, v19, v15
    v_perm_b32 v32, v20, v20, v14
    v_perm_b32 v33, v20, v20, v15
    v_perm_b32 v34, v21, v21, v14
    v_perm_b32 v35, v21, v21, v15
    v_perm_b32 v36, v22, v22, v14
    v_perm_b32 v37, v22, v22, v15
    v_perm_b32 v38, v23, v23, v14
    v_perm_b32 v39, v23, v23, v15
    v_perm_b32 v192, v208, v208, v14
    v_perm_b32 v193, v208, v208, v15
    v_perm_b32 v194, v209, v209, v14
    v_perm_b32 v195, v209, v209, v15
    v_perm_b32 v196, v210, v210, v14
    v_perm_b32 v197, v210, v210, v15
    v_perm_b32 v198, v211, v211, v14
    v_perm_b32 v199, v211, v211, v15
    v_perm_b32 v200, v212, v212, v14
    v_perm_b32 v201, v212, v212, v15
    v_perm_b32 v202, v213, v213, v14
    v_perm_b32 v203, v213, v213, v15
    v_perm_b32 v204, v214, v214, v14
    v_perm_b32 v205, v214, v214, v15
    v_perm_b32 v206, v215, v215, v14
    v_perm_b32 v207, v215, v215, v15
    v_lshlrev_b32 v72, 16, v64
    v_lshlrev_b32 v76, 16, v68
    v_and_b32 v64, 0xffff0000, v64
    v_and_b32 v68, 0xffff0000, v68
    v_lshlrev_b32 v73, 16, v65
    v_lshlrev_b32 v77, 16, v69
    v_and_b32 v65, 0xffff0000, v65
    v_and_b32 v69, 0xffff0000, v69
    v_lshlrev_b32 v74, 16, v66
    v_lshlrev_b32 v78, 16, v70
    v_and_b32 v66, 0xffff0000, v66
    v_and_b32 v70, 0xffff0000, v70
    v_lshlrev_b32 v75, 16, v67
    v_lshlrev_b32 v79, 16, v71
    v_and_b32 v67, 0xffff0000, v67
    v_and_b32 v71, 0xffff0000, v71
    v_mul_f32 v72, v72, v76
    v_mul_f32 v64, v64, v68
    v_mul_f32 v73, v73, v77
    v_mul_f32 v65, v65, v69
    v_mul_f32 v74, v74, v78
    v_mul_f32 v66, v66, v70
    v_mul_f32 v75, v75, v79
    v_mul_f32 v67, v67, v71
    v_cvt_pk_bf16_f32 v72, 0, v72
    v_cvt_pk_bf16_f32 v64, 0, v64
    v_cvt_pk_bf16_f32 v73, 0, v73
    v_cvt_pk_bf16_f32 v65, 0, v65
    v_cvt_pk_bf16_f32 v74, 0, v74
    v_cvt_pk_bf16_f32 v66, 0, v66
    v_cvt_pk_bf16_f32 v75, 0, v75
    v_cvt_pk_bf16_f32 v67, 0, v67
    v_add_f32 v72, v72, v64
    v_add_f32 v73, v73, v65
    v_add_f32 v74, v74, v66
    v_add_f32 v75, v75, v67
    v_add_f32 v72, v72, v73
    v_add_f32 v74, v74, v75
    v_add_f32 v4, v72, v74
    s_nop 1
    v_add_f32_dpp v4, v4, v4 row_ror:8 row_mask:0xf bank_mask:0xf
    s_nop 1
    v_add_f32_dpp v4, v4, v4 row_ror:4 row_mask:0xf bank_mask:0xf
    s_nop 1
    v_add_f32_dpp v4, v4, v4 row_ror:2 row_mask:0xf bank_mask:0xf
    s_nop 1
    v_add_f32_dpp v4, v4, v4 row_ror:1 row_mask:0xf bank_mask:0xf
    v_mov_b32 v3, v4
    s_nop 1
    v_permlane16_swap_b32 v4, v3
    v_add_f32 v4, v4, v3
    ds_write_b32 v235, v4 offset:64
    s_waitcnt lgkmcnt(0)
    s_barrier
    buffer_load_dwordx4 v[64:67], v11, s[20:23], s58 offen nt
    s_add_u32 s58, s58, 14336
    buffer_load_dwordx4 v[68:71], v11, s[20:23], s58 offen nt
    s_add_u32 s58, s58, 14336
    buffer_load_dwordx4 v[72:75], v11, s[20:23], s58 offen nt
    s_add_u32 s58, s58, 14336
    buffer_load_dwordx4 v[76:79], v11, s[20:23], s58 offen nt
    s_add_u32 s58, s58, 14336
    buffer_load_dwordx4 v[80:83], v11, s[20:23], s58 offen nt
    s_add_u32 s58, s58, 14336
    ds_read_b128 v[4:7], v234 offset:64
    s_waitcnt lgkmcnt(0)
    v_add_f32 v4, v4, v5
    v_add_f32 v6, v6, v7
    v_add_f32 v4, v4, v6
    v_cvt_pk_bf16_f32 v4, 0, v4
    v_mul_f32 v232, 0xbfb8aa3b, v4
    v_exp_f32 v232, v232
    s_nop 0
    v_add_f32 v232, 1.0, v232
    v_rcp_f32 v232, v232
    s_nop 0
    v_cvt_pk_bf16_f32 v232, 0, v232
    v_sub_f32 v233, 1.0, v232
    v_cvt_pk_bf16_f32 v233, 0, v233
    s_waitcnt vmcnt(4)
    buffer_load_dwordx4 v[84:87], v11, s[20:23], s58 offen nt
    s_add_u32 s58, s58, 14336
    v_mfma_f32_16x16x16_bf16 v[40:43], v[24:25], v[64:65], 0
    v_mfma_f32_16x16x16_bf16 v[44:47], v[24:25], v[66:67], 0
    s_waitcnt vmcnt(4)
    buffer_load_dwordx4 v[88:91], v11, s[20:23], s58 offen nt
    s_add_u32 s58, s58, 14336
    v_mfma_f32_16x16x16_bf16 v[40:43], v[26:27], v[68:69], v[40:43]
    v_mfma_f32_16x16x16_bf16 v[44:47], v[26:27], v[70:71], v[44:47]
    s_waitcnt vmcnt(4)
    buffer_load_dwordx4 v[92:95], v11, s[20:23], s58 offen nt
    s_add_u32 s58, s58, s94
    v_mfma_f32_16x16x16_bf16 v[40:43], v[28:29], v[72:73], v[40:43]
    v_mfma_f32_16x16x16_bf16 v[44:47], v[28:29], v[74:75], v[44:47]
    s_waitcnt vmcnt(4)
    buffer_load_dwordx4 v[96:99], v246, s[20:23], s58 offen nt
    s_add_u32 s58, s58, 14336
    v_mfma_f32_16x16x16_bf16 v[40:43], v[30:31], v[76:77], v[40:43]
    v_mfma_f32_16x16x16_bf16 v[44:47], v[30:31], v[78:79], v[44:47]
    s_waitcnt vmcnt(4)
    buffer_load_dwordx4 v[100:103], v246, s[20:23], s58 offen nt
    s_add_u32 s58, s58, 14336
    v_mfma_f32_16x16x16_bf16 v[40:43], v[32:33], v[80:81], v[40:43]
    v_mfma_f32_16x16x16_bf16 v[44:47], v[32:33], v[82:83], v[44:47]
    s_waitcnt vmcnt(4)
    buffer_load_dwordx4 v[104:107], v246, s[20:23], s58 offen nt
    s_add_u32 s58, s58, 14336
    v_mfma_f32_16x16x16_bf16 v[40:43], v[34:35], v[84:85], v[40:43]
    v_mfma_f32_16x16x16_bf16 v[44:47], v[34:35], v[86:87], v[44:47]
    s_waitcnt vmcnt(4)
    buffer_load_dwordx4 v[108:111], v246, s[20:23], s58 offen nt
    s_add_u32 s58, s58, 14336
    v_mfma_f32_16x16x16_bf16 v[40:43], v[36:37], v[88:89], v[40:43]
    v_mfma_f32_16x16x16_bf16 v[44:47], v[36:37], v[90:91], v[44:47]
    s_waitcnt vmcnt(4)
    buffer_load_dwordx4 v[112:115], v246, s[20:23], s58 offen nt
    s_add_u32 s58, s58, 14336
    v_mfma_f32_16x16x16_bf16 v[40:43], v[38:39], v[92:93], v[40:43]
    v_mfma_f32_16x16x16_bf16 v[44:47], v[38:39], v[94:95], v[44:47]
    s_waitcnt vmcnt(4)
    buffer_load_dwordx4 v[116:119], v246, s[20:23], s58 offen nt
    s_add_u32 s58, s58, 14336
    v_mfma_f32_16x16x16_bf16 v[40:43], v[192:193], v[96:97], v[40:43]
    v_mfma_f32_16x16x16_bf16 v[44:47], v[192:193], v[98:99], v[44:47]
    ds_write_b8 v244, v8 offset:24
    s_waitcnt vmcnt(4)
    buffer_load_dwordx4 v[120:123], v246, s[20:23], s58 offen nt
    s_add_u32 s58, s58, 14336
    v_mfma_f32_16x16x16_bf16 v[40:43], v[194:195], v[100:101], v[40:43]
    v_mfma_f32_16x16x16_bf16 v[44:47], v[194:195], v[102:103], v[44:47]
    s_waitcnt vmcnt(4)
    buffer_load_dwordx4 v[124:127], v246, s[20:23], s58 offen nt
    v_mfma_f32_16x16x16_bf16 v[40:43], v[196:197], v[104:105], v[40:43]
    v_mfma_f32_16x16x16_bf16 v[44:47], v[196:197], v[106:107], v[44:47]
    s_waitcnt vmcnt(4)
    buffer_load_dwordx4 v[128:131], v12, s[28:31], s60 offen nt
    v_mfma_f32_16x16x16_bf16 v[40:43], v[198:199], v[108:109], v[40:43]
    v_mfma_f32_16x16x16_bf16 v[44:47], v[198:199], v[110:111], v[44:47]
    s_waitcnt vmcnt(4)
    buffer_load_dwordx4 v[144:147], v12, s[28:31], s60 offen offset:2048 nt
    s_add_u32 s60, s60, 0x10000
    v_mfma_f32_16x16x16_bf16 v[40:43], v[200:201], v[112:113], v[40:43]
    v_mfma_f32_16x16x16_bf16 v[44:47], v[200:201], v[114:115], v[44:47]
    s_waitcnt vmcnt(4)
    buffer_load_dwordx4 v[132:135], v12, s[28:31], s60 offen nt
    v_mfma_f32_16x16x16_bf16 v[40:43], v[202:203], v[116:117], v[40:43]
    v_mfma_f32_16x16x16_bf16 v[44:47], v[202:203], v[118:119], v[44:47]
    s_waitcnt vmcnt(4)
    buffer_load_dwordx4 v[148:151], v12, s[28:31], s60 offen offset:2048 nt
    s_add_u32 s60, s60, 0x10000
    v_mfma_f32_16x16x16_bf16 v[40:43], v[204:205], v[120:121], v[40:43]
    v_mfma_f32_16x16x16_bf16 v[44:47], v[204:205], v[122:123], v[44:47]
    s_waitcnt vmcnt(4)
    buffer_load_dwordx4 v[136:139], v12, s[28:31], s60 offen nt
    v_mfma_f32_16x16x16_bf16 v[40:43], v[206:207], v[124:125], v[40:43]
    v_mfma_f32_16x16x16_bf16 v[44:47], v[206:207], v[126:127], v[44:47]
    s_nop 7
    v_permlane16_swap_b32 v40, v44
    v_permlane16_swap_b32 v41, v45
    v_permlane16_swap_b32 v42, v46
    v_permlane16_swap_b32 v43, v47
    v_add_f32_dpp v40, v44, v40 row_ror:8 row_mask:0xf bank_mask:0x3
    v_add_f32_dpp v41, v45, v41 row_ror:8 row_mask:0xf bank_mask:0x3
    v_add_f32_dpp v42, v46, v42 row_ror:8 row_mask:0xf bank_mask:0x3
    v_add_f32_dpp v43, v47, v43 row_ror:8 row_mask:0xf bank_mask:0x3
    ds_write_b128 v236, v[40:43] offset:6144
    ds_write_b8 v240, v8 offset:8
    s_waitcnt vmcnt(4)
    buffer_load_dwordx4 v[152:155], v12, s[28:31], s60 offen offset:2048 nt
    s_add_u32 s60, s60, 0x10000
    s_waitcnt vmcnt(4)
    buffer_load_dwordx4 v[140:143], v12, s[28:31], s60 offen nt
    s_waitcnt vmcnt(4)
    buffer_load_dwordx4 v[156:159], v12, s[28:31], s60 offen offset:2048 nt
    s_waitcnt vmcnt(4)
    buffer_load_dwordx4 v[160:163], v13, s[32:35], s61 offen nt
    s_add_u32 s61, s61, 0x2000
    s_waitcnt vmcnt(4)
    buffer_load_dwordx4 v[164:167], v13, s[32:35], s61 offen nt
    s_add_u32 s61, s61, 0x2000
    s_waitcnt vmcnt(4)
    buffer_load_dwordx4 v[168:171], v13, s[32:35], s61 offen nt
    s_add_u32 s61, s61, 0x2000
    s_waitcnt vmcnt(4)
    buffer_load_dwordx4 v[172:175], v13, s[32:35], s61 offen nt
    s_add_u32 s61, s61, 0x2000
    ds_write_b8 v238, v8 offset:26
    ds_write_b8 v238, v8 offset:28
    s_waitcnt vmcnt(4)
    buffer_load_dwordx4 v[176:179], v13, s[32:35], s61 offen nt
    s_add_u32 s61, s61, 0x2000
    s_waitcnt vmcnt(4)
    buffer_load_dwordx4 v[180:183], v13, s[32:35], s61 offen nt
    s_add_u32 s61, s61, 0x2000
    ds_write_b8 v244, v8 offset:26
    ds_write_b8 v244, v8 offset:28
    s_waitcnt vmcnt(4)
    buffer_load_dwordx4 v[184:187], v13, s[32:35], s61 offen nt
L_join:
L_im:
    s_sub_u32 s56, s56, 1
    s_cbranch_scc1 L_end
    ds_read_u8 v3, v244 offset:12
    ds_read_u8 v4, v244 offset:14
    ds_read_b128 v[188:191], v243 offset:512
    ds_read_b128 v[16:19], v243 offset:1024
    s_waitcnt lgkmcnt(0)
    v_cmp_eq_u32 vcc, 1, v3
    s_cbranch_vccnz L_of
    v_cmp_ne_u32 vcc, 1, v4
    s_cbranch_vccnz L_im
    v_perm_b32 v192, v16, v16, v56
    v_perm_b32 v193, v16, v16, v57
    v_perm_b32 v194, v16, v16, v58
    v_perm_b32 v195, v16, v16, v59
    v_perm_b32 v196, v16, v16, v60
    v_perm_b32 v197, v16, v16, v61
    v_perm_b32 v198, v16, v16, v62
    v_perm_b32 v199, v16, v16, v63
    s_waitcnt vmcnt(6)
    v_mfma_f32_16x16x32_bf16 v[228:231], v[192:195], v[160:163], 0
    v_perm_b32 v200, v17, v17, v56
    v_perm_b32 v201, v17, v17, v57
    v_perm_b32 v202, v17, v17, v58
    v_perm_b32 v203, v17, v17, v59
    s_waitcnt vmcnt(5)
    v_mfma_f32_16x16x32_bf16 v[228:231], v[196:199], v[164:167], v[228:231]
    v_perm_b32 v204, v17, v17, v60
    v_perm_b32 v205, v17, v17, v61
    v_perm_b32 v206, v17, v17, v62
    v_perm_b32 v207, v17, v17, v63
    s_waitcnt vmcnt(4)
    v_mfma_f32_16x16x32_bf16 v[228:231], v[200:203], v[168:171], v[228:231]
    v_perm_b32 v208, v18, v18, v56
    v_perm_b32 v209, v18, v18, v57
    v_perm_b32 v210, v18, v18, v58
    v_perm_b32 v211, v18, v18, v59
    s_waitcnt vmcnt(3)
    v_mfma_f32_16x16x32_bf16 v[228:231], v[204:207], v[172:175], v[228:231]
    v_perm_b32 v212, v18, v18, v60
    v_perm_b32 v213, v18, v18, v61
    v_perm_b32 v214, v18, v18, v62
    v_perm_b32 v215, v18, v18, v63
    s_waitcnt vmcnt(2)
    v_mfma_f32_16x16x32_bf16 v[228:231], v[208:211], v[176:179], v[228:231]
    v_perm_b32 v216, v19, v19, v56
    v_perm_b32 v217, v19, v19, v57
    v_perm_b32 v218, v19, v19, v58
    v_perm_b32 v219, v19, v19, v59
    s_waitcnt vmcnt(1)
    v_mfma_f32_16x16x32_bf16 v[228:231], v[212:215], v[180:183], v[228:231]
    s_waitcnt vmcnt(0)
    v_mfma_f32_16x16x32_bf16 v[228:231], v[216:219], v[184:187], v[228:231]
L_oi:
    s_sub_u32 s56, s56, 1
    s_cbranch_scc1 L_end
    ds_read_u8 v3, v244 offset:12
    ds_read_b128 v[188:191], v243 offset:512
    s_waitcnt lgkmcnt(0)
    v_cmp_ne_u32 vcc, 1, v3
    s_cbranch_vccnz L_oi
    v_perm_b32 v192, v188, v188, v56
    v_perm_b32 v193, v188, v188, v57
    v_perm_b32 v194, v188, v188, v58
    v_perm_b32 v195, v188, v188, v59
    v_perm_b32 v196, v188, v188, v60
    v_perm_b32 v197, v188, v188, v61
    v_perm_b32 v198, v188, v188, v62
    v_perm_b32 v199, v188, v188, v63
    v_mfma_f32_16x16x32_bf16 v[224:227], v[192:195], v[128:131], 0
    v_perm_b32 v200, v189, v189, v56
    v_perm_b32 v201, v189, v189, v57
    v_perm_b32 v202, v189, v189, v58
    v_perm_b32 v203, v189, v189, v59
    v_mfma_f32_16x16x32_bf16 v[224:227], v[196:199], v[132:135], v[224:227]
    v_perm_b32 v204, v189, v189, v60
    v_perm_b32 v205, v189, v189, v61
    v_perm_b32 v206, v189, v189, v62
    v_perm_b32 v207, v189, v189, v63
    v_mfma_f32_16x16x32_bf16 v[224:227], v[200:203], v[136:139], v[224:227]
    v_perm_b32 v208, v190, v190, v56
    v_perm_b32 v209, v190, v190, v57
    v_perm_b32 v210, v190, v190, v58
    v_perm_b32 v211, v190, v190, v59
    v_mfma_f32_16x16x32_bf16 v[224:227], v[204:207], v[140:143], v[224:227]
    v_perm_b32 v212, v190, v190, v60
    v_perm_b32 v213, v190, v190, v61
    v_perm_b32 v214, v190, v190, v62
    v_perm_b32 v215, v190, v190, v63
    v_mfma_f32_16x16x32_bf16 v[224:227], v[208:211], v[144:147], v[224:227]
    v_perm_b32 v216, v191, v191, v56
    v_perm_b32 v217, v191, v191, v57
    v_perm_b32 v218, v191, v191, v58
    v_perm_b32 v219, v191, v191, v59
    v_mfma_f32_16x16x32_bf16 v[224:227], v[212:215], v[148:151], v[224:227]
    v_perm_b32 v220, v191, v191, v60
    v_perm_b32 v221, v191, v191, v61
    v_perm_b32 v222, v191, v191, v62
    v_perm_b32 v223, v191, v191, v63
    v_mfma_f32_16x16x32_bf16 v[224:227], v[216:219], v[152:155], v[224:227]
    s_nop 0
    v_mfma_f32_16x16x32_bf16 v[224:227], v[220:223], v[156:159], v[224:227]
    s_nop 7
    v_pk_mul_f32 v[224:225], v[232:233], v[224:225] op_sel:[0,0] op_sel_hi:[0,1]
    v_pk_mul_f32 v[226:227], v[232:233], v[226:227] op_sel:[0,0] op_sel_hi:[0,1]
    s_branch L_mix
L_of:
    v_cmp_eq_u32 vcc, 1, v4
    v_perm_b32 v192, v188, v188, v56
    v_perm_b32 v193, v188, v188, v57
    v_perm_b32 v194, v188, v188, v58
    v_perm_b32 v195, v188, v188, v59
    v_perm_b32 v196, v188, v188, v60
    v_perm_b32 v197, v188, v188, v61
    v_perm_b32 v198, v188, v188, v62
    v_perm_b32 v199, v188, v188, v63
    s_waitcnt vmcnt(7)
    v_mfma_f32_16x16x32_bf16 v[224:227], v[192:195], v[128:131], 0
    v_perm_b32 v200, v189, v189, v56
    v_perm_b32 v201, v189, v189, v57
    v_perm_b32 v202, v189, v189, v58
    v_perm_b32 v203, v189, v189, v59
    v_mfma_f32_16x16x32_bf16 v[224:227], v[196:199], v[132:135], v[224:227]
    v_perm_b32 v204, v189, v189, v60
    v_perm_b32 v205, v189, v189, v61
    v_perm_b32 v206, v189, v189, v62
    v_perm_b32 v207, v189, v189, v63
    v_mfma_f32_16x16x32_bf16 v[224:227], v[200:203], v[136:139], v[224:227]
    v_perm_b32 v208, v190, v190, v56
    v_perm_b32 v209, v190, v190, v57
    v_perm_b32 v210, v190, v190, v58
    v_perm_b32 v211, v190, v190, v59
    v_mfma_f32_16x16x32_bf16 v[224:227], v[204:207], v[140:143], v[224:227]
    v_perm_b32 v212, v190, v190, v60
    v_perm_b32 v213, v190, v190, v61
    v_perm_b32 v214, v190, v190, v62
    v_perm_b32 v215, v190, v190, v63
    v_mfma_f32_16x16x32_bf16 v[224:227], v[208:211], v[144:147], v[224:227]
    v_perm_b32 v216, v191, v191, v56
    v_perm_b32 v217, v191, v191, v57
    v_perm_b32 v218, v191, v191, v58
    v_perm_b32 v219, v191, v191, v59
    v_mfma_f32_16x16x32_bf16 v[224:227], v[212:215], v[148:151], v[224:227]
    v_perm_b32 v220, v191, v191, v60
    v_perm_b32 v221, v191, v191, v61
    v_perm_b32 v222, v191, v191, v62
    v_perm_b32 v223, v191, v191, v63
    v_mfma_f32_16x16x32_bf16 v[224:227], v[216:219], v[152:155], v[224:227]
    s_nop 0
    v_mfma_f32_16x16x32_bf16 v[224:227], v[220:223], v[156:159], v[224:227]
    s_cbranch_vccnz L_hok
L_hi:
    s_sub_u32 s56, s56, 1
    s_cbranch_scc1 L_end
    ds_read_u8 v3, v244 offset:14
    ds_read_b128 v[16:19], v243 offset:1024
    s_waitcnt lgkmcnt(0)
    v_cmp_ne_u32 vcc, 1, v3
    s_cbranch_vccnz L_hi
L_hok:
    v_perm_b32 v192, v16, v16, v56
    v_perm_b32 v193, v16, v16, v57
    v_perm_b32 v194, v16, v16, v58
    v_perm_b32 v195, v16, v16, v59
    v_perm_b32 v196, v16, v16, v60
    v_perm_b32 v197, v16, v16, v61
    v_perm_b32 v198, v16, v16, v62
    v_perm_b32 v199, v16, v16, v63
    s_waitcnt vmcnt(6)
    v_mfma_f32_16x16x32_bf16 v[228:231], v[192:195], v[160:163], 0
    v_perm_b32 v200, v17, v17, v56
    v_perm_b32 v201, v17, v17, v57
    v_perm_b32 v202, v17, v17, v58
    v_perm_b32 v203, v17, v17, v59
    s_waitcnt vmcnt(5)
    v_mfma_f32_16x16x32_bf16 v[228:231], v[196:199], v[164:167], v[228:231]
    v_perm_b32 v204, v17, v17, v60
    v_perm_b32 v205, v17, v17, v61
    v_perm_b32 v206, v17, v17, v62
    v_perm_b32 v207, v17, v17, v63
    s_waitcnt vmcnt(4)
    v_mfma_f32_16x16x32_bf16 v[228:231], v[200:203], v[168:171], v[228:231]
    v_perm_b32 v208, v18, v18, v56
    v_perm_b32 v209, v18, v18, v57
    v_perm_b32 v210, v18, v18, v58
    v_perm_b32 v211, v18, v18, v59
    s_waitcnt vmcnt(3)
    v_mfma_f32_16x16x32_bf16 v[228:231], v[204:207], v[172:175], v[228:231]
    v_perm_b32 v212, v18, v18, v60
    v_perm_b32 v213, v18, v18, v61
    v_perm_b32 v214, v18, v18, v62
    v_perm_b32 v215, v18, v18, v63
    s_waitcnt vmcnt(2)
    v_mfma_f32_16x16x32_bf16 v[228:231], v[208:211], v[176:179], v[228:231]
    v_perm_b32 v216, v19, v19, v56
    v_perm_b32 v217, v19, v19, v57
    v_perm_b32 v218, v19, v19, v58
    v_perm_b32 v219, v19, v19, v59
    s_waitcnt vmcnt(1)
    v_mfma_f32_16x16x32_bf16 v[228:231], v[212:215], v[180:183], v[228:231]
    v_mul_f32 v224, v232, v224
    v_mul_f32 v225, v232, v225
    v_mul_f32 v226, v232, v226
    v_mul_f32 v227, v232, v227
    s_waitcnt vmcnt(0)
    v_mfma_f32_16x16x32_bf16 v[228:231], v[216:219], v[184:187], v[228:231]
    s_nop 7
L_mix:
    v_pk_fma_f32 v[224:225], v[232:233], v[228:229], v[224:225] op_sel:[1,0,0] op_sel_hi:[1,1,1]
    v_pk_fma_f32 v[226:227], v[232:233], v[230:231], v[226:227] op_sel:[1,0,0] op_sel_hi:[1,1,1]
    ds_write_b128 v236, v[224:227] offset:10240
    s_mov_b64 exec, 1
    ds_add_rtn_u32 v3, v9, v8 offset:16
    ds_read_b32 v4, v9 offset:20
    s_mov_b64 exec, -1
    ds_read_b128 v[192:195], v255 offset:10240
    ds_read_b128 v[196:199], v255 offset:11264
    ds_read_b128 v[200:203], v255 offset:12288
    ds_read_b128 v[204:207], v255 offset:13312
    s_waitcnt lgkmcnt(4)
    v_readfirstlane_b32 s57, v3
    v_readfirstlane_b32 s95, v4
    s_cmp_lg_u32 s57, 3
    s_waitcnt lgkmcnt(0)
    s_cbranch_scc1 L_end
    v_pk_add_f32 v[192:193], v[192:193], v[196:197]
    v_pk_add_f32 v[194:195], v[194:195], v[198:199]
    v_pk_add_f32 v[200:201], v[200:201], v[204:205]
    v_pk_add_f32 v[202:203], v[202:203], v[206:207]
    v_pk_add_f32 v[192:193], v[192:193], v[200:201]
    v_pk_add_f32 v[194:195], v[194:195], v[202:203]
    v_bfi_b32 v192, v2, s52, v192
    v_bfi_b32 v193, v2, s53, v193
    v_bfi_b32 v194, v2, s54, v194
    v_bfi_b32 v195, v2, s55, v195
    s_cmp_eq_u32 s95, 0
    s_cbranch_scc1 L_pf_near
    buffer_store_dwordx4 v[192:195], v241, s[40:43], s68 offen sc1
    s_branch L_pf_out
L_pf_near:
    buffer_store_dwordx4 v[192:195], v241, s[40:43], s68 offen
L_pf_out:
    s_cmp_lg_u32 s67, 0
    s_cbranch_scc1 L_end
L_fin:
    s_sub_u32 s56, s56, 1
    s_cbranch_scc1 L_end
    buffer_load_dwordx4 v[40:43], v242, s[40:43], s69 offen sc1
    buffer_load_dwordx4 v[44:47], v242, s[40:43], s69 offen offset:1024 sc1
    s_waitcnt vmcnt(0)
    v_xor_b32 v40, s52, v40
    v_xor_b32 v41, s53, v41
    v_xor_b32 v42, s54, v42
    v_xor_b32 v43, s55, v43
    v_xor_b32 v44, s52, v44
    v_xor_b32 v45, s53, v45
    v_xor_b32 v46, s54, v46
    v_xor_b32 v47, s55, v47
    v_or3_b32 v3, v40, v41, v42
    v_or3_b32 v3, v3, v43, v44
    v_or3_b32 v3, v3, v45, v46
    v_bitop3_b32 v3, v3, v47, v2 bitop3:0xa8
    v_cmp_ne_u32 vcc, 0, v3
    s_wqm_b64 exec, vcc
    s_cbranch_vccnz L_fin
    s_mov_b64 exec, -1
    v_pk_add_f32 v[40:41], v[40:41], v[44:45]
    v_pk_add_f32 v[42:43], v[42:43], v[46:47]
    s_nop 1
    v_permlane32_swap_b32 v40, v42
    v_permlane32_swap_b32 v41, v43
    v_add_f32 v40, v40, v42
    v_add_f32 v41, v41, v43
    s_nop 1
    v_permlane16_swap_b32 v40, v41
    v_add_f32 v40, v40, v41
    s_nop 1
    v_add_f32_dpp v40, v40, v40 row_ror:8 row_mask:0xf bank_mask:0xf
    s_nop 1
    v_add_f32_dpp v40, v40, v40 row_ror:4 row_mask:0xf bank_mask:0xf
    v_cvt_pk_bf16_f32 v40, 0, v40
    s_mov_b32 exec_lo, 0xf000f
    s_mov_b32 exec_hi, 0xf000f
    buffer_store_short_d16_hi v40, v245, s[44:47], s66 offen
    s_cmp_lg_u32 s2, 0
    s_cbranch_scc1 L_end
    s_mov_b64 exec, 1
    v_mov_b32 v3, s51
    buffer_store_dword v3, v9, s[40:43], 0 offen
L_end:
L_exit:
    s_endpgm
.section .rodata,"a"
.p2align 6
.amdhsa_kernel gated_mix__sliding_block_cached__glu_gated_glu__decode_kernel
  .amdhsa_next_free_vgpr 256
  .amdhsa_next_free_sgpr 102
  .amdhsa_accum_offset 256
  .amdhsa_group_segment_fixed_size 0
  .amdhsa_kernarg_size 104
  .amdhsa_user_sgpr_count 2
  .amdhsa_user_sgpr_kernarg_segment_ptr 1
  .amdhsa_system_sgpr_workgroup_id_x 1
.end_amdhsa_kernel
```
